```python
import torch

def _softmax(x, axis=-1):
    return torch.softmax(x, dim=axis)
def _gelu(x):
    return torch.nn.functional.gelu(x, approximate="tanh")
def _silu(x):
    return torch.nn.functional.silu(x)
def _sigmoid(x):
    return torch.sigmoid(x)
def _layernorm(x, axis=-1, eps=1e-5):
    m = x.mean(dim=axis, keepdim=True)
    v = x.var(dim=axis, keepdim=True, unbiased=False)
    return (x - m) / torch.sqrt(v + eps)
def _scatter_add(tgt, idx, src, axis=0):
    return tgt.clone().index_add_(axis, idx, src)
def _segment_sum(src, seg, n):
    out = torch.zeros((n,) + src.shape[1:], dtype=src.dtype)
    return out.index_add_(0, seg, src)
def _pad(x, pw):
    flat = tuple(v for pair in reversed(pw) for v in pair)
    return torch.nn.functional.pad(x, flat)

kernel_name = 'standalone__gqa_softmax__sampling'

def setup_inputs():

    _w = (lambda a: (lambda t: t.to(torch.bfloat16) if t.is_floating_point() else t)(torch.as_tensor(a)))
    B, Hq, Hkv, Sq, Sk, D = 16, 32, 8, 4, 2048, 128
    return {
        "q": _w((lambda *s: torch.randn(*s, dtype=torch.bfloat16) * 0.8)(B, Hq, Sq, D)),
        "k": _w((lambda *s: torch.randn(*s, dtype=torch.bfloat16) * 0.8)(B, Hkv, Sk, D)),
        "v": _w((lambda *s: torch.randn(*s, dtype=torch.bfloat16) * 0.05)(B, Hkv, Sk, D)),
    }

def reference(q, k, v):
    B, Hq, Sq, D = q.shape
    Hkv = k.shape[1]
    rep = Hq // Hkv
    k = (lambda x, n, axis: torch.repeat_interleave(x, n, dim=axis))(k, rep, axis=1)
    v = (lambda x, n, axis: torch.repeat_interleave(x, n, dim=axis))(v, rep, axis=1)
    scale = D ** -0.5
    scores = torch.einsum("bhqd,bhkd->bhqk", q, k) * scale
    p = _softmax(scores, axis=-1)
    return torch.einsum("bhqk,bhkd->bhqd", p, v)
```

```asm
; @launch grid=(256,1,1) block=(256,1,1) lds=64
.amdgcn_target "amdgcn-amd-amdhsa--gfx950"
.text
.globl standalone__gqa_softmax__sampling_kernel
.p2align 8
.type standalone__gqa_softmax__sampling_kernel,@function
standalone__gqa_softmax__sampling_kernel:
  s_cmp_ge_u32 s2, 256
  s_cbranch_scc1 L_end
  s_load_dwordx2 s[8:9], s[0:1], 8
  s_load_dwordx2 s[12:13], s[0:1], 16
  s_load_dwordx2 s[16:17], s[0:1], 0
  s_load_dwordx2 s[20:21], s[0:1], 24
  s_load_dwordx2 s[24:25], s[0:1], 32
  s_load_dwordx2 s[28:29], s[0:1], 40
  s_memrealtime s[44:45]
  v_lshrrev_b32 v16, 6, v0
  v_and_b32 v1, 63, v0
  v_readfirstlane_b32 s3, v16
  v_and_b32 v16, 48, v1
  v_and_b32 v17, 15, v1
  v_lshl_add_u32 v5, v17, 8, v16
  v_lshlrev_b32 v18, 6, v16
  v_lshl_add_u32 v7, v17, 4, v18
  v_add_u32 v8, 4096, v7
  v_add_u32 v2, 4096, v5
  v_lshlrev_b32 v3, 4, v1
  v_add_u32 v4, 4096, v3
  v_mov_b32 v12, 0
  v_mul_u32_u24 v16, 3, v16
  v_add_u32 v6, v5, v16
  s_and_b32 s40, s2, 7
  s_lshr_b32 s41, s2, 4
  s_lshl_b32 s4, s40, 4
  s_or_b32 s4, s4, s41
  s_bfe_u32 s5, s2, 0x10003
  s_lshl_b32 s34, s4, 19
  s_lshl_b32 s40, s5, 18
  s_add_u32 s34, s34, s40
  s_mov_b32 s35, s34
  s_lshl_b32 s36, s4, 12
  s_mov_b32 s10, 0x4000000
  s_mov_b32 s11, 0x20000
  s_mov_b32 s14, 0x4000000
  s_mov_b32 s15, 0x20000
  s_mov_b32 s18, 0x80000
  s_mov_b32 s19, 0x20000
  s_mov_b32 s22, 0x80000
  s_mov_b32 s23, 0x20000
  s_mov_b32 s26, 0x100
  s_mov_b32 s27, 0x20000
  s_mov_b32 s30, 0x10000000
  s_mov_b32 s31, 0x20000
  s_cmp_lg_u32 s3, 0
  s_waitcnt lgkmcnt(0)
  s_cbranch_scc1 L_helper
  buffer_load_dwordx4 a[20:23], v5, s[8:11], s34 offen offset:0 nt
  buffer_load_dwordx4 v[120:123], v7, s[12:15], s35 offen offset:0 nt
  buffer_load_dwordx4 a[0:3], v5, s[16:19], s36 offen offset:0
  buffer_load_dwordx4 a[24:27], v5, s[8:11], s34 offen offset:64 nt
  buffer_load_dwordx4 a[28:31], v5, s[8:11], s34 offen offset:128 nt
  buffer_load_dwordx4 a[32:35], v5, s[8:11], s34 offen offset:192 nt
  buffer_load_dwordx4 a[36:39], v2, s[8:11], s34 offen offset:0 nt
  buffer_load_dwordx4 a[40:43], v2, s[8:11], s34 offen offset:64 nt
  buffer_load_dwordx4 a[44:47], v2, s[8:11], s34 offen offset:128 nt
  buffer_load_dwordx4 a[48:51], v2, s[8:11], s34 offen offset:192 nt
  buffer_load_dwordx4 a[4:7], v5, s[16:19], s36 offen offset:64
  buffer_load_dwordx4 a[8:11], v5, s[16:19], s36 offen offset:128
  buffer_load_dwordx4 a[12:15], v5, s[16:19], s36 offen offset:192
  s_add_u32 s34, s34, 8192
  buffer_load_dwordx4 v[124:127], v7, s[12:15], s35 offen offset:256 nt
  buffer_load_dwordx4 v[128:131], v7, s[12:15], s35 offen offset:512 nt
  buffer_load_dwordx4 v[132:135], v7, s[12:15], s35 offen offset:768 nt
  buffer_load_dwordx4 v[136:139], v8, s[12:15], s35 offen offset:0 nt
  buffer_load_dwordx4 v[140:143], v8, s[12:15], s35 offen offset:256 nt
  buffer_load_dwordx4 v[144:147], v8, s[12:15], s35 offen offset:512 nt
  buffer_load_dwordx4 v[148:151], v8, s[12:15], s35 offen offset:768 nt
  s_add_u32 s35, s35, 8192
  buffer_load_dwordx4 a[52:55], v5, s[8:11], s34 offen offset:0 nt
  buffer_load_dwordx4 a[56:59], v5, s[8:11], s34 offen offset:64 nt
  buffer_load_dwordx4 a[60:63], v5, s[8:11], s34 offen offset:128 nt
  buffer_load_dwordx4 a[64:67], v5, s[8:11], s34 offen offset:192 nt
  buffer_load_dwordx4 a[68:71], v2, s[8:11], s34 offen offset:0 nt
  buffer_load_dwordx4 a[72:75], v2, s[8:11], s34 offen offset:64 nt
  buffer_load_dwordx4 a[76:79], v2, s[8:11], s34 offen offset:128 nt
  buffer_load_dwordx4 a[80:83], v2, s[8:11], s34 offen offset:192 nt
  s_add_u32 s34, s34, 8192
  buffer_load_dwordx4 v[152:155], v7, s[12:15], s35 offen offset:0 nt
  buffer_load_dwordx4 v[156:159], v7, s[12:15], s35 offen offset:256 nt
  buffer_load_dwordx4 v[160:163], v7, s[12:15], s35 offen offset:512 nt
  buffer_load_dwordx4 v[164:167], v7, s[12:15], s35 offen offset:768 nt
  buffer_load_dwordx4 v[168:171], v8, s[12:15], s35 offen offset:0 nt
  buffer_load_dwordx4 v[172:175], v8, s[12:15], s35 offen offset:256 nt
  buffer_load_dwordx4 v[176:179], v8, s[12:15], s35 offen offset:512 nt
  buffer_load_dwordx4 v[180:183], v8, s[12:15], s35 offen offset:768 nt
  s_add_u32 s35, s35, 8192
  buffer_load_dwordx4 a[84:87], v5, s[8:11], s34 offen offset:0 nt
  buffer_load_dwordx4 a[88:91], v5, s[8:11], s34 offen offset:64 nt
  buffer_load_dwordx4 a[92:95], v5, s[8:11], s34 offen offset:128 nt
  buffer_load_dwordx4 a[96:99], v5, s[8:11], s34 offen offset:192 nt
  buffer_load_dwordx4 a[100:103], v2, s[8:11], s34 offen offset:0 nt
  buffer_load_dwordx4 a[104:107], v2, s[8:11], s34 offen offset:64 nt
  buffer_load_dwordx4 a[108:111], v2, s[8:11], s34 offen offset:128 nt
  buffer_load_dwordx4 a[112:115], v2, s[8:11], s34 offen offset:192 nt
  s_add_u32 s34, s34, 8192
  buffer_load_dwordx4 v[184:187], v7, s[12:15], s35 offen offset:0 nt
  buffer_load_dwordx4 v[188:191], v7, s[12:15], s35 offen offset:256 nt
  buffer_load_dwordx4 v[192:195], v7, s[12:15], s35 offen offset:512 nt
  buffer_load_dwordx4 v[196:199], v7, s[12:15], s35 offen offset:768 nt
  buffer_load_dwordx4 v[200:203], v8, s[12:15], s35 offen offset:0 nt
  buffer_load_dwordx4 v[204:207], v8, s[12:15], s35 offen offset:256 nt
  buffer_load_dwordx4 v[208:211], v8, s[12:15], s35 offen offset:512 nt
  buffer_load_dwordx4 v[212:215], v8, s[12:15], s35 offen offset:768 nt
  s_add_u32 s35, s35, 8192
  s_mov_b32 s37, 0x3e0293ee
  s_mov_b32 s38, 0x05040100
  s_mov_b32 s39, 0x07060302
  s_lshl_b32 s42, s4, 14
  s_lshl_b32 s40, s5, 13
  s_add_u32 s42, s42, s40
  s_xor_b32 s46, s42, 8192
  s_mov_b32 s6, 0
  s_mov_b32 s32, 31
  s_mov_b32 s33, 3
  s_mov_b32 s7, 2
  v_mov_b32 v116, 0xff7fffff
  v_mov_b32 v40, 0
  v_mov_b32 v41, 0
  v_mov_b32 v42, 0
  v_mov_b32 v43, 0
  v_mov_b32 v44, 0
  v_mov_b32 v45, 0
  v_mov_b32 v46, 0
  v_mov_b32 v47, 0
  v_mov_b32 v48, 0
  v_mov_b32 v49, 0
  v_mov_b32 v50, 0
  v_mov_b32 v51, 0
  v_mov_b32 v52, 0
  v_mov_b32 v53, 0
  v_mov_b32 v54, 0
  v_mov_b32 v55, 0
  v_mov_b32 v56, 0
  v_mov_b32 v57, 0
  v_mov_b32 v58, 0
  v_mov_b32 v59, 0
  v_mov_b32 v60, 0
  v_mov_b32 v61, 0
  v_mov_b32 v62, 0
  v_mov_b32 v63, 0
  v_mov_b32 v64, 0
  v_mov_b32 v65, 0
  v_mov_b32 v66, 0
  v_mov_b32 v67, 0
  v_mov_b32 v68, 0
  v_mov_b32 v69, 0
  v_mov_b32 v70, 0
  v_mov_b32 v71, 0
  v_mov_b32 v72, 0
  v_mov_b32 v73, 0
  v_mov_b32 v74, 0
  v_mov_b32 v75, 0
  v_mov_b32 v16, 0x3f803f80
  v_accvgpr_write_b32 a16, v16
  v_accvgpr_write_b32 a17, v16
  v_accvgpr_write_b32 a18, v16
  v_accvgpr_write_b32 a19, v16
  s_waitcnt vmcnt(39)
.p2align 6
L_loop:
L_p0:
  s_waitcnt vmcnt(40)
  s_cmp_lg_u32 s32, 1
  s_cbranch_scc1 L_w0
  s_waitcnt vmcnt(24)
L_w0:
  v_mfma_f32_16x16x32_bf16 v[20:23], a[20:23], a[0:3], 0
  v_mfma_f32_16x16x32_bf16 v[24:27], a[36:39], a[0:3], 0
  v_mfma_f32_16x16x32_bf16 v[20:23], a[24:27], a[4:7], v[20:23]
  v_mfma_f32_16x16x32_bf16 v[24:27], a[40:43], a[4:7], v[24:27]
  v_mfma_f32_16x16x32_bf16 v[20:23], a[28:31], a[8:11], v[20:23]
  v_mfma_f32_16x16x32_bf16 v[24:27], a[44:47], a[8:11], v[24:27]
  v_mfma_f32_16x16x32_bf16 v[20:23], a[32:35], a[12:15], v[20:23]
  v_mfma_f32_16x16x32_bf16 v[24:27], a[48:51], a[12:15], v[24:27]
  s_cmp_ge_u32 s32, s33
  s_cbranch_scc0 L_nok0
  buffer_load_dwordx4 a[20:23], v5, s[8:11], s34 offen offset:0 nt
  buffer_load_dwordx4 a[24:27], v5, s[8:11], s34 offen offset:64 nt
  buffer_load_dwordx4 a[28:31], v5, s[8:11], s34 offen offset:128 nt
  buffer_load_dwordx4 a[32:35], v5, s[8:11], s34 offen offset:192 nt
  buffer_load_dwordx4 a[36:39], v2, s[8:11], s34 offen offset:0 nt
  buffer_load_dwordx4 a[40:43], v2, s[8:11], s34 offen offset:64 nt
  buffer_load_dwordx4 a[44:47], v2, s[8:11], s34 offen offset:128 nt
  buffer_load_dwordx4 a[48:51], v2, s[8:11], s34 offen offset:192 nt
L_back0:
  s_add_u32 s34, s34, 8192
  v_max3_f32 v17, v20, v21, v22
  v_max3_f32 v18, v23, v24, v25
  v_max3_f32 v17, v17, v26, v27
  v_max3_f32 v17, v17, v18, v116
  v_mov_b32 v16, v17
  s_nop 1
  v_permlane16_swap_b32 v16, v17
  v_max_f32 v17, v17, v16
  v_mov_b32 v16, v17
  s_nop 1
  v_permlane32_swap_b32 v16, v17
  v_max_f32 v17, v17, v16
  v_sub_f32 v18, v116, v17
  v_mul_f32 v9, s37, v17
  v_mul_f32 v18, s37, v18
  v_mov_b32 v116, v17
  v_exp_f32 v14, v18
  v_fma_f32 v20, v20, s37, -v9
  v_fma_f32 v21, v21, s37, -v9
  v_fma_f32 v22, v22, s37, -v9
  v_fma_f32 v23, v23, s37, -v9
  v_fma_f32 v24, v24, s37, -v9
  v_fma_f32 v25, v25, s37, -v9
  v_fma_f32 v26, v26, s37, -v9
  v_fma_f32 v27, v27, s37, -v9
  v_exp_f32 v20, v20
  v_exp_f32 v21, v21
  v_exp_f32 v22, v22
  v_exp_f32 v23, v23
  v_exp_f32 v24, v24
  v_exp_f32 v25, v25
  v_exp_f32 v26, v26
  v_exp_f32 v27, v27
  v_pk_mul_f32 v[40:41], v[40:41], v[14:15] op_sel_hi:[1,0]
  v_pk_mul_f32 v[42:43], v[42:43], v[14:15] op_sel_hi:[1,0]
  v_pk_mul_f32 v[44:45], v[44:45], v[14:15] op_sel_hi:[1,0]
  v_pk_mul_f32 v[46:47], v[46:47], v[14:15] op_sel_hi:[1,0]
  v_pk_mul_f32 v[48:49], v[48:49], v[14:15] op_sel_hi:[1,0]
  v_pk_mul_f32 v[50:51], v[50:51], v[14:15] op_sel_hi:[1,0]
  v_pk_mul_f32 v[52:53], v[52:53], v[14:15] op_sel_hi:[1,0]
  v_pk_mul_f32 v[54:55], v[54:55], v[14:15] op_sel_hi:[1,0]
  v_pk_mul_f32 v[56:57], v[56:57], v[14:15] op_sel_hi:[1,0]
  v_pk_mul_f32 v[58:59], v[58:59], v[14:15] op_sel_hi:[1,0]
  v_pk_mul_f32 v[60:61], v[60:61], v[14:15] op_sel_hi:[1,0]
  v_pk_mul_f32 v[62:63], v[62:63], v[14:15] op_sel_hi:[1,0]
  v_pk_mul_f32 v[64:65], v[64:65], v[14:15] op_sel_hi:[1,0]
  v_pk_mul_f32 v[66:67], v[66:67], v[14:15] op_sel_hi:[1,0]
  v_pk_mul_f32 v[68:69], v[68:69], v[14:15] op_sel_hi:[1,0]
  v_pk_mul_f32 v[70:71], v[70:71], v[14:15] op_sel_hi:[1,0]
  v_pk_mul_f32 v[72:73], v[72:73], v[14:15] op_sel_hi:[1,0]
  v_cvt_pk_bf16_f32 v28, v20, v21
  v_cvt_pk_bf16_f32 v29, v22, v23
  v_cvt_pk_bf16_f32 v30, v24, v25
  v_cvt_pk_bf16_f32 v31, v26, v27
  s_nop 1
  v_mfma_f32_16x16x32_bf16 v[72:75], a[16:19], v[28:31], v[72:75]
  s_waitcnt vmcnt(40)
  s_cmp_lg_u32 s32, 1
  s_cbranch_scc1 L_w1
  s_waitcnt vmcnt(19)
L_w1:
  v_perm_b32 v32, v124, v120, s38
  v_perm_b32 v33, v132, v128, s38
  v_perm_b32 v34, v140, v136, s38
  v_perm_b32 v35, v148, v144, s38
  v_perm_b32 v36, v124, v120, s39
  v_perm_b32 v37, v132, v128, s39
  v_perm_b32 v38, v140, v136, s39
  v_perm_b32 v39, v148, v144, s39
  v_mfma_f32_16x16x32_bf16 v[40:43], v[32:35], v[28:31], v[40:43]
  v_perm_b32 v32, v125, v121, s38
  v_perm_b32 v33, v133, v129, s38
  v_perm_b32 v34, v141, v137, s38
  v_perm_b32 v35, v149, v145, s38
  v_mfma_f32_16x16x32_bf16 v[44:47], v[36:39], v[28:31], v[44:47]
  v_perm_b32 v36, v125, v121, s39
  v_perm_b32 v37, v133, v129, s39
  v_perm_b32 v38, v141, v137, s39
  v_perm_b32 v39, v149, v145, s39
  v_mfma_f32_16x16x32_bf16 v[48:51], v[32:35], v[28:31], v[48:51]
  v_perm_b32 v32, v126, v122, s38
  v_perm_b32 v33, v134, v130, s38
  v_perm_b32 v34, v142, v138, s38
  v_perm_b32 v35, v150, v146, s38
  v_mfma_f32_16x16x32_bf16 v[52:55], v[36:39], v[28:31], v[52:55]
  v_perm_b32 v36, v126, v122, s39
  v_perm_b32 v37, v134, v130, s39
  v_perm_b32 v38, v142, v138, s39
  v_perm_b32 v39, v150, v146, s39
  v_mfma_f32_16x16x32_bf16 v[56:59], v[32:35], v[28:31], v[56:59]
  v_perm_b32 v32, v127, v123, s38
  v_perm_b32 v33, v135, v131, s38
  v_perm_b32 v34, v143, v139, s38
  v_perm_b32 v35, v151, v147, s38
  v_mfma_f32_16x16x32_bf16 v[60:63], v[36:39], v[28:31], v[60:63]
  v_perm_b32 v36, v127, v123, s39
  v_perm_b32 v37, v135, v131, s39
  v_perm_b32 v38, v143, v139, s39
  v_perm_b32 v39, v151, v147, s39
  v_mfma_f32_16x16x32_bf16 v[64:67], v[32:35], v[28:31], v[64:67]
  s_sub_u32 s32, s32, 1
  s_nop 0
  v_mfma_f32_16x16x32_bf16 v[68:71], v[36:39], v[28:31], v[68:71]
  s_cmp_ge_u32 s32, s7
  s_cbranch_scc0 L_skipv0
  buffer_load_dwordx4 v[120:123], v7, s[12:15], s35 offen offset:0 nt
  buffer_load_dwordx4 v[124:127], v7, s[12:15], s35 offen offset:256 nt
  buffer_load_dwordx4 v[128:131], v7, s[12:15], s35 offen offset:512 nt
  buffer_load_dwordx4 v[132:135], v7, s[12:15], s35 offen offset:768 nt
  buffer_load_dwordx4 v[136:139], v8, s[12:15], s35 offen offset:0 nt
  buffer_load_dwordx4 v[140:143], v8, s[12:15], s35 offen offset:256 nt
  buffer_load_dwordx4 v[144:147], v8, s[12:15], s35 offen offset:512 nt
  buffer_load_dwordx4 v[148:151], v8, s[12:15], s35 offen offset:768 nt
L_skipv0:
  s_add_u32 s35, s35, 8192
L_p1:
  s_waitcnt vmcnt(40)
  s_cmp_lg_u32 s32, 0
  s_cbranch_scc1 L_w2
  s_waitcnt vmcnt(11)
L_w2:
  v_mfma_f32_16x16x32_bf16 v[20:23], a[52:55], a[0:3], 0
  v_mfma_f32_16x16x32_bf16 v[24:27], a[68:71], a[0:3], 0
  v_mfma_f32_16x16x32_bf16 v[20:23], a[56:59], a[4:7], v[20:23]
  v_mfma_f32_16x16x32_bf16 v[24:27], a[72:75], a[4:7], v[24:27]
  v_mfma_f32_16x16x32_bf16 v[20:23], a[60:63], a[8:11], v[20:23]
  v_mfma_f32_16x16x32_bf16 v[24:27], a[76:79], a[8:11], v[24:27]
  v_mfma_f32_16x16x32_bf16 v[20:23], a[64:67], a[12:15], v[20:23]
  v_mfma_f32_16x16x32_bf16 v[24:27], a[80:83], a[12:15], v[24:27]
  s_cmp_ge_u32 s32, s33
  s_cbranch_scc0 L_nok1
  buffer_load_dwordx4 a[52:55], v5, s[8:11], s34 offen offset:0 nt
  buffer_load_dwordx4 a[56:59], v5, s[8:11], s34 offen offset:64 nt
  buffer_load_dwordx4 a[60:63], v5, s[8:11], s34 offen offset:128 nt
  buffer_load_dwordx4 a[64:67], v5, s[8:11], s34 offen offset:192 nt
  buffer_load_dwordx4 a[68:71], v2, s[8:11], s34 offen offset:0 nt
  buffer_load_dwordx4 a[72:75], v2, s[8:11], s34 offen offset:64 nt
  buffer_load_dwordx4 a[76:79], v2, s[8:11], s34 offen offset:128 nt
  buffer_load_dwordx4 a[80:83], v2, s[8:11], s34 offen offset:192 nt
L_back1:
  s_add_u32 s34, s34, 8192
  v_max3_f32 v17, v20, v21, v22
  v_max3_f32 v18, v23, v24, v25
  v_max3_f32 v17, v17, v26, v27
  v_max3_f32 v17, v17, v18, v116
  v_mov_b32 v16, v17
  s_nop 1
  v_permlane16_swap_b32 v16, v17
  v_max_f32 v17, v17, v16
  v_mov_b32 v16, v17
  s_nop 1
  v_permlane32_swap_b32 v16, v17
  v_max_f32 v17, v17, v16
  v_sub_f32 v18, v116, v17
  v_mul_f32 v9, s37, v17
  v_mul_f32 v18, s37, v18
  v_mov_b32 v116, v17
  v_exp_f32 v14, v18
  v_fma_f32 v20, v20, s37, -v9
  v_fma_f32 v21, v21, s37, -v9
  v_fma_f32 v22, v22, s37, -v9
  v_fma_f32 v23, v23, s37, -v9
  v_fma_f32 v24, v24, s37, -v9
  v_fma_f32 v25, v25, s37, -v9
  v_fma_f32 v26, v26, s37, -v9
  v_fma_f32 v27, v27, s37, -v9
  v_exp_f32 v20, v20
  v_exp_f32 v21, v21
  v_exp_f32 v22, v22
  v_exp_f32 v23, v23
  v_exp_f32 v24, v24
  v_exp_f32 v25, v25
  v_exp_f32 v26, v26
  v_exp_f32 v27, v27
  v_pk_mul_f32 v[40:41], v[40:41], v[14:15] op_sel_hi:[1,0]
  v_pk_mul_f32 v[42:43], v[42:43], v[14:15] op_sel_hi:[1,0]
  v_pk_mul_f32 v[44:45], v[44:45], v[14:15] op_sel_hi:[1,0]
  v_pk_mul_f32 v[46:47], v[46:47], v[14:15] op_sel_hi:[1,0]
  v_pk_mul_f32 v[48:49], v[48:49], v[14:15] op_sel_hi:[1,0]
  v_pk_mul_f32 v[50:51], v[50:51], v[14:15] op_sel_hi:[1,0]
  v_pk_mul_f32 v[52:53], v[52:53], v[14:15] op_sel_hi:[1,0]
  v_pk_mul_f32 v[54:55], v[54:55], v[14:15] op_sel_hi:[1,0]
  v_pk_mul_f32 v[56:57], v[56:57], v[14:15] op_sel_hi:[1,0]
  v_pk_mul_f32 v[58:59], v[58:59], v[14:15] op_sel_hi:[1,0]
  v_pk_mul_f32 v[60:61], v[60:61], v[14:15] op_sel_hi:[1,0]
  v_pk_mul_f32 v[62:63], v[62:63], v[14:15] op_sel_hi:[1,0]
  v_pk_mul_f32 v[64:65], v[64:65], v[14:15] op_sel_hi:[1,0]
  v_pk_mul_f32 v[66:67], v[66:67], v[14:15] op_sel_hi:[1,0]
  v_pk_mul_f32 v[68:69], v[68:69], v[14:15] op_sel_hi:[1,0]
  v_pk_mul_f32 v[70:71], v[70:71], v[14:15] op_sel_hi:[1,0]
  v_pk_mul_f32 v[72:73], v[72:73], v[14:15] op_sel_hi:[1,0]
  v_cvt_pk_bf16_f32 v28, v20, v21
  v_cvt_pk_bf16_f32 v29, v22, v23
  v_cvt_pk_bf16_f32 v30, v24, v25
  v_cvt_pk_bf16_f32 v31, v26, v27
  s_nop 1
  v_mfma_f32_16x16x32_bf16 v[72:75], a[16:19], v[28:31], v[72:75]
  s_waitcnt vmcnt(40)
  s_cmp_lg_u32 s32, 0
  s_cbranch_scc1 L_w3
  s_waitcnt vmcnt(3)
L_w3:
  v_perm_b32 v32, v156, v152, s38
  v_perm_b32 v33, v164, v160, s38
  v_perm_b32 v34, v172, v168, s38
  v_perm_b32 v35, v180, v176, s38
  v_perm_b32 v36, v156, v152, s39
  v_perm_b32 v37, v164, v160, s39
  v_perm_b32 v38, v172, v168, s39
  v_perm_b32 v39, v180, v176, s39
  v_mfma_f32_16x16x32_bf16 v[40:43], v[32:35], v[28:31], v[40:43]
  v_perm_b32 v32, v157, v153, s38
  v_perm_b32 v33, v165, v161, s38
  v_perm_b32 v34, v173, v169, s38
  v_perm_b32 v35, v181, v177, s38
  v_mfma_f32_16x16x32_bf16 v[44:47], v[36:39], v[28:31], v[44:47]
  v_perm_b32 v36, v157, v153, s39
  v_perm_b32 v37, v165, v161, s39
  v_perm_b32 v38, v173, v169, s39
  v_perm_b32 v39, v181, v177, s39
  v_mfma_f32_16x16x32_bf16 v[48:51], v[32:35], v[28:31], v[48:51]
  v_max_f32 v18, 0x00800000, v72
  v_perm_b32 v32, v158, v154, s38
  v_perm_b32 v33, v166, v162, s38
  v_perm_b32 v34, v174, v170, s38
  v_perm_b32 v35, v182, v178, s38
  v_mfma_f32_16x16x32_bf16 v[52:55], v[36:39], v[28:31], v[52:55]
  v_rcp_f32 v118, v18
  v_log_f32 v18, v18
  v_perm_b32 v36, v158, v154, s39
  v_perm_b32 v37, v166, v162, s39
  v_perm_b32 v38, v174, v170, s39
  v_perm_b32 v39, v182, v178, s39
  v_mfma_f32_16x16x32_bf16 v[56:59], v[32:35], v[28:31], v[56:59]
  v_perm_b32 v32, v159, v155, s38
  v_perm_b32 v33, v167, v163, s38
  v_perm_b32 v34, v175, v171, s38
  v_perm_b32 v35, v183, v179, s38
  v_mfma_f32_16x16x32_bf16 v[60:63], v[36:39], v[28:31], v[60:63]
  v_perm_b32 v36, v159, v155, s39
  v_perm_b32 v37, v167, v163, s39
  v_perm_b32 v38, v175, v171, s39
  v_perm_b32 v39, v183, v179, s39
  v_mfma_f32_16x16x32_bf16 v[64:67], v[32:35], v[28:31], v[64:67]
  s_sub_u32 s32, s32, 1
  v_add_f32 v88, v9, v18
  v_mfma_f32_16x16x32_bf16 v[68:71], v[36:39], v[28:31], v[68:71]
  s_cbranch_scc1 L_epi
  s_cmp_ge_u32 s32, s7
  s_cbranch_scc0 L_skipv1
  buffer_load_dwordx4 v[152:155], v7, s[12:15], s35 offen offset:0 nt
  buffer_load_dwordx4 v[156:159], v7, s[12:15], s35 offen offset:256 nt
  buffer_load_dwordx4 v[160:163], v7, s[12:15], s35 offen offset:512 nt
  buffer_load_dwordx4 v[164:167], v7, s[12:15], s35 offen offset:768 nt
  buffer_load_dwordx4 v[168:171], v8, s[12:15], s35 offen offset:0 nt
  buffer_load_dwordx4 v[172:175], v8, s[12:15], s35 offen offset:256 nt
  buffer_load_dwordx4 v[176:179], v8, s[12:15], s35 offen offset:512 nt
  buffer_load_dwordx4 v[180:183], v8, s[12:15], s35 offen offset:768 nt
L_skipv1:
  s_add_u32 s35, s35, 8192
L_p2:
  s_waitcnt vmcnt(40)
  v_mfma_f32_16x16x32_bf16 v[20:23], a[84:87], a[0:3], 0
  v_mfma_f32_16x16x32_bf16 v[24:27], a[100:103], a[0:3], 0
  v_mfma_f32_16x16x32_bf16 v[20:23], a[88:91], a[4:7], v[20:23]
  v_mfma_f32_16x16x32_bf16 v[24:27], a[104:107], a[4:7], v[24:27]
  v_mfma_f32_16x16x32_bf16 v[20:23], a[92:95], a[8:11], v[20:23]
  v_mfma_f32_16x16x32_bf16 v[24:27], a[108:111], a[8:11], v[24:27]
  v_mfma_f32_16x16x32_bf16 v[20:23], a[96:99], a[12:15], v[20:23]
  v_mfma_f32_16x16x32_bf16 v[24:27], a[112:115], a[12:15], v[24:27]
  s_cmp_ge_u32 s32, s33
  s_cbranch_scc0 L_nok2
  buffer_load_dwordx4 a[84:87], v5, s[8:11], s34 offen offset:0 nt
  buffer_load_dwordx4 a[88:91], v5, s[8:11], s34 offen offset:64 nt
  buffer_load_dwordx4 a[92:95], v5, s[8:11], s34 offen offset:128 nt
  buffer_load_dwordx4 a[96:99], v5, s[8:11], s34 offen offset:192 nt
  buffer_load_dwordx4 a[100:103], v2, s[8:11], s34 offen offset:0 nt
  buffer_load_dwordx4 a[104:107], v2, s[8:11], s34 offen offset:64 nt
  buffer_load_dwordx4 a[108:111], v2, s[8:11], s34 offen offset:128 nt
  buffer_load_dwordx4 a[112:115], v2, s[8:11], s34 offen offset:192 nt
L_back2:
  s_add_u32 s34, s34, 8192
  v_max3_f32 v17, v20, v21, v22
  v_max3_f32 v18, v23, v24, v25
  v_max3_f32 v17, v17, v26, v27
  v_max3_f32 v17, v17, v18, v116
  v_mov_b32 v16, v17
  s_nop 1
  v_permlane16_swap_b32 v16, v17
  v_max_f32 v17, v17, v16
  v_mov_b32 v16, v17
  s_nop 1
  v_permlane32_swap_b32 v16, v17
  v_max_f32 v17, v17, v16
  v_sub_f32 v18, v116, v17
  v_mul_f32 v9, s37, v17
  v_mul_f32 v18, s37, v18
  v_mov_b32 v116, v17
  v_exp_f32 v14, v18
  v_fma_f32 v20, v20, s37, -v9
  v_fma_f32 v21, v21, s37, -v9
  v_fma_f32 v22, v22, s37, -v9
  v_fma_f32 v23, v23, s37, -v9
  v_fma_f32 v24, v24, s37, -v9
  v_fma_f32 v25, v25, s37, -v9
  v_fma_f32 v26, v26, s37, -v9
  v_fma_f32 v27, v27, s37, -v9
  v_exp_f32 v20, v20
  v_exp_f32 v21, v21
  v_exp_f32 v22, v22
  v_exp_f32 v23, v23
  v_exp_f32 v24, v24
  v_exp_f32 v25, v25
  v_exp_f32 v26, v26
  v_exp_f32 v27, v27
  v_pk_mul_f32 v[40:41], v[40:41], v[14:15] op_sel_hi:[1,0]
  v_pk_mul_f32 v[42:43], v[42:43], v[14:15] op_sel_hi:[1,0]
  v_pk_mul_f32 v[44:45], v[44:45], v[14:15] op_sel_hi:[1,0]
  v_pk_mul_f32 v[46:47], v[46:47], v[14:15] op_sel_hi:[1,0]
  v_pk_mul_f32 v[48:49], v[48:49], v[14:15] op_sel_hi:[1,0]
  v_pk_mul_f32 v[50:51], v[50:51], v[14:15] op_sel_hi:[1,0]
  v_pk_mul_f32 v[52:53], v[52:53], v[14:15] op_sel_hi:[1,0]
  v_pk_mul_f32 v[54:55], v[54:55], v[14:15] op_sel_hi:[1,0]
  v_pk_mul_f32 v[56:57], v[56:57], v[14:15] op_sel_hi:[1,0]
  v_pk_mul_f32 v[58:59], v[58:59], v[14:15] op_sel_hi:[1,0]
  v_pk_mul_f32 v[60:61], v[60:61], v[14:15] op_sel_hi:[1,0]
  v_pk_mul_f32 v[62:63], v[62:63], v[14:15] op_sel_hi:[1,0]
  v_pk_mul_f32 v[64:65], v[64:65], v[14:15] op_sel_hi:[1,0]
  v_pk_mul_f32 v[66:67], v[66:67], v[14:15] op_sel_hi:[1,0]
  v_pk_mul_f32 v[68:69], v[68:69], v[14:15] op_sel_hi:[1,0]
  v_pk_mul_f32 v[70:71], v[70:71], v[14:15] op_sel_hi:[1,0]
  v_pk_mul_f32 v[72:73], v[72:73], v[14:15] op_sel_hi:[1,0]
  v_cvt_pk_bf16_f32 v28, v20, v21
  v_cvt_pk_bf16_f32 v29, v22, v23
  v_cvt_pk_bf16_f32 v30, v24, v25
  v_cvt_pk_bf16_f32 v31, v26, v27
  s_nop 1
  v_mfma_f32_16x16x32_bf16 v[72:75], a[16:19], v[28:31], v[72:75]
  s_waitcnt vmcnt(40)
  s_cmp_lg_u32 s32, 2
  s_cbranch_scc1 L_w4
  s_waitcnt vmcnt(32)
L_w4:
  v_perm_b32 v32, v188, v184, s38
  v_perm_b32 v33, v196, v192, s38
  v_perm_b32 v34, v204, v200, s38
  v_perm_b32 v35, v212, v208, s38
  v_perm_b32 v36, v188, v184, s39
  v_perm_b32 v37, v196, v192, s39
  v_perm_b32 v38, v204, v200, s39
  v_perm_b32 v39, v212, v208, s39
  v_mfma_f32_16x16x32_bf16 v[40:43], v[32:35], v[28:31], v[40:43]
  v_perm_b32 v32, v189, v185, s38
  v_perm_b32 v33, v197, v193, s38
  v_perm_b32 v34, v205, v201, s38
  v_perm_b32 v35, v213, v209, s38
  v_mfma_f32_16x16x32_bf16 v[44:47], v[36:39], v[28:31], v[44:47]
  v_perm_b32 v36, v189, v185, s39
  v_perm_b32 v37, v197, v193, s39
  v_perm_b32 v38, v205, v201, s39
  v_perm_b32 v39, v213, v209, s39
  v_mfma_f32_16x16x32_bf16 v[48:51], v[32:35], v[28:31], v[48:51]
  v_perm_b32 v32, v190, v186, s38
  v_perm_b32 v33, v198, v194, s38
  v_perm_b32 v34, v206, v202, s38
  v_perm_b32 v35, v214, v210, s38
  v_mfma_f32_16x16x32_bf16 v[52:55], v[36:39], v[28:31], v[52:55]
  v_perm_b32 v36, v190, v186, s39
  v_perm_b32 v37, v198, v194, s39
  v_perm_b32 v38, v206, v202, s39
  v_perm_b32 v39, v214, v210, s39
  v_mfma_f32_16x16x32_bf16 v[56:59], v[32:35], v[28:31], v[56:59]
  v_perm_b32 v32, v191, v187, s38
  v_perm_b32 v33, v199, v195, s38
  v_perm_b32 v34, v207, v203, s38
  v_perm_b32 v35, v215, v211, s38
  v_mfma_f32_16x16x32_bf16 v[60:63], v[36:39], v[28:31], v[60:63]
  v_perm_b32 v36, v191, v187, s39
  v_perm_b32 v37, v199, v195, s39
  v_perm_b32 v38, v207, v203, s39
  v_perm_b32 v39, v215, v211, s39
  v_mfma_f32_16x16x32_bf16 v[64:67], v[32:35], v[28:31], v[64:67]
  s_sub_u32 s32, s32, 1
  s_nop 0
  v_mfma_f32_16x16x32_bf16 v[68:71], v[36:39], v[28:31], v[68:71]
  s_cmp_ge_u32 s32, s7
  s_cbranch_scc0 L_skipv2
  buffer_load_dwordx4 v[184:187], v7, s[12:15], s35 offen offset:0 nt
  buffer_load_dwordx4 v[188:191], v7, s[12:15], s35 offen offset:256 nt
  buffer_load_dwordx4 v[192:195], v7, s[12:15], s35 offen offset:512 nt
  buffer_load_dwordx4 v[196:199], v7, s[12:15], s35 offen offset:768 nt
  buffer_load_dwordx4 v[200:203], v8, s[12:15], s35 offen offset:0 nt
  buffer_load_dwordx4 v[204:207], v8, s[12:15], s35 offen offset:256 nt
  buffer_load_dwordx4 v[208:211], v8, s[12:15], s35 offen offset:512 nt
  buffer_load_dwordx4 v[212:215], v8, s[12:15], s35 offen offset:768 nt
L_skipv2:
  s_add_u32 s35, s35, 8192
  s_cbranch_execnz L_loop
  s_endpgm
L_nok0:
  s_cmp_eq_u32 s32, 1
  s_cbranch_scc1 L_last
  s_nop 7
  s_branch L_back0
L_nok1:
  s_nop 7
  s_branch L_back1
L_nok2:
  s_nop 7
  s_branch L_back2
L_last:
  s_cbranch_execz L_epi
  s_barrier
  ds_read_b64 v[10:11], v12
  s_waitcnt lgkmcnt(0)
  v_readfirstlane_b32 s43, v11
  v_mov_b32 v91, v10
  v_mov_b32 v95, v10
  v_mov_b32 v99, v10
  s_lshl_b32 s47, s5, 1
  s_or_b32 s47, s47, s43
  buffer_load_dwordx4 v[76:79], v3, s[28:31], s42 offen offset:0 sc1
  buffer_load_dwordx4 v[80:83], v3, s[28:31], s42 offen offset:1024 sc1
  buffer_load_dwordx4 v[84:87], v3, s[28:31], s42 offen offset:2048 sc1
  s_branch L_back0
L_far0:
  v_pk_mul_f32 v[42:43], v[42:43], v[118:119] op_sel_hi:[1,0]
  v_pk_mul_f32 v[46:47], v[46:47], v[118:119] op_sel_hi:[1,0]
  v_cvt_pk_bf16_f32 v89, v42, v43
  v_cvt_pk_bf16_f32 v90, v46, v47
  v_pk_mul_f32 v[50:51], v[50:51], v[118:119] op_sel_hi:[1,0]
  v_pk_mul_f32 v[54:55], v[54:55], v[118:119] op_sel_hi:[1,0]
  v_pk_mul_f32 v[58:59], v[58:59], v[118:119] op_sel_hi:[1,0]
  v_cvt_pk_bf16_f32 v92, v50, v51
  v_cvt_pk_bf16_f32 v93, v54, v55
  v_cvt_pk_bf16_f32 v94, v58, v59
  v_pk_mul_f32 v[62:63], v[62:63], v[118:119] op_sel_hi:[1,0]
  v_pk_mul_f32 v[66:67], v[66:67], v[118:119] op_sel_hi:[1,0]
  v_pk_mul_f32 v[70:71], v[70:71], v[118:119] op_sel_hi:[1,0]
  v_cvt_pk_bf16_f32 v96, v62, v63
  v_cvt_pk_bf16_f32 v97, v66, v67
  v_cvt_pk_bf16_f32 v98, v70, v71
  s_cbranch_execz L_chk0
  buffer_store_dwordx4 v[88:91], v3, s[28:31], s46 offen offset:0 sc1
  buffer_store_dwordx4 v[92:95], v3, s[28:31], s46 offen offset:1024 sc1
  buffer_store_dwordx4 v[96:99], v3, s[28:31], s46 offen offset:2048 sc1
  s_branch L_retry0
L_far1:
  v_pk_mul_f32 v[40:41], v[40:41], v[118:119] op_sel_hi:[1,0]
  v_pk_mul_f32 v[44:45], v[44:45], v[118:119] op_sel_hi:[1,0]
  v_cvt_pk_bf16_f32 v89, v40, v41
  v_cvt_pk_bf16_f32 v90, v44, v45
  v_pk_mul_f32 v[48:49], v[48:49], v[118:119] op_sel_hi:[1,0]
  v_pk_mul_f32 v[52:53], v[52:53], v[118:119] op_sel_hi:[1,0]
  v_pk_mul_f32 v[56:57], v[56:57], v[118:119] op_sel_hi:[1,0]
  v_cvt_pk_bf16_f32 v92, v48, v49
  v_cvt_pk_bf16_f32 v93, v52, v53
  v_cvt_pk_bf16_f32 v94, v56, v57
  v_pk_mul_f32 v[60:61], v[60:61], v[118:119] op_sel_hi:[1,0]
  v_pk_mul_f32 v[64:65], v[64:65], v[118:119] op_sel_hi:[1,0]
  v_pk_mul_f32 v[68:69], v[68:69], v[118:119] op_sel_hi:[1,0]
  v_cvt_pk_bf16_f32 v96, v60, v61
  v_cvt_pk_bf16_f32 v97, v64, v65
  v_cvt_pk_bf16_f32 v98, v68, v69
  s_cbranch_execz L_chk1
  buffer_store_dwordx4 v[88:91], v3, s[28:31], s46 offen offset:0 sc1
  buffer_store_dwordx4 v[92:95], v3, s[28:31], s46 offen offset:1024 sc1
  buffer_store_dwordx4 v[96:99], v3, s[28:31], s46 offen offset:2048 sc1
  s_branch L_retry1
L_epi:
  s_cmp_eq_u32 s47, 3
  s_cbranch_scc1 L_tail1
  s_cmp_eq_u32 s47, 1
  s_cbranch_scc1 L_tail0
  s_cmp_eq_u32 s47, 0
  s_cbranch_scc1 L_far0
  s_branch L_far1
L_tail0:
  s_cbranch_execz L_dry0
  v_pk_mul_f32 v[42:43], v[42:43], v[118:119] op_sel_hi:[1,0]
  v_pk_mul_f32 v[46:47], v[46:47], v[118:119] op_sel_hi:[1,0]
  v_cvt_pk_bf16_f32 v89, v42, v43
  v_cvt_pk_bf16_f32 v90, v46, v47
  buffer_store_dwordx4 v[88:91], v3, s[28:31], s46 offen offset:0
  v_pk_mul_f32 v[50:51], v[50:51], v[118:119] op_sel_hi:[1,0]
  v_pk_mul_f32 v[54:55], v[54:55], v[118:119] op_sel_hi:[1,0]
  v_pk_mul_f32 v[58:59], v[58:59], v[118:119] op_sel_hi:[1,0]
  v_cvt_pk_bf16_f32 v92, v50, v51
  v_cvt_pk_bf16_f32 v93, v54, v55
  v_cvt_pk_bf16_f32 v94, v58, v59
  buffer_store_dwordx4 v[92:95], v3, s[28:31], s46 offen offset:1024
  v_pk_mul_f32 v[62:63], v[62:63], v[118:119] op_sel_hi:[1,0]
  v_pk_mul_f32 v[66:67], v[66:67], v[118:119] op_sel_hi:[1,0]
  v_pk_mul_f32 v[70:71], v[70:71], v[118:119] op_sel_hi:[1,0]
  v_cvt_pk_bf16_f32 v96, v62, v63
  v_cvt_pk_bf16_f32 v97, v66, v67
  v_cvt_pk_bf16_f32 v98, v70, v71
  buffer_store_dwordx4 v[96:99], v3, s[28:31], s46 offen offset:2048
L_retry0:
  buffer_load_dwordx4 v[76:79], v3, s[28:31], s42 offen offset:0 sc1
  buffer_load_dwordx4 v[80:83], v3, s[28:31], s42 offen offset:1024 sc1
  buffer_load_dwordx4 v[84:87], v3, s[28:31], s42 offen offset:2048 sc1
  s_add_u32 s6, s6, 1
  s_cmp_gt_u32 s6, 0x400000
  s_cbranch_scc1 L_got0
L_dry0:
  s_waitcnt vmcnt(0)
L_chk0:
  v_xor_b32 v16, v79, v10
  v_max_f32 v18, v88, v76
  v_bitop3_b32 v16, v16, v83, v10 bitop3:0xf6
  v_sub_f32 v17, v88, v18
  v_bitop3_b32 v16, v16, v87, v10 bitop3:0xf6
  v_sub_f32 v18, v76, v18
  v_cmp_ne_u32 vcc, 0, v16
  v_exp_f32 v14, v17
  v_exp_f32 v18, v18
  s_cbranch_vccnz L_retry0
L_got0:
  v_lshlrev_b32 v100, 16, v77
  v_and_b32 v101, 0xffff0000, v77
  v_add_f32 v16, v14, v18
  v_mul_f32 v14, v14, v118
  v_rcp_f32 v16, v16
  v_lshlrev_b32 v102, 16, v78
  v_and_b32 v103, 0xffff0000, v78
  v_lshlrev_b32 v104, 16, v80
  v_and_b32 v105, 0xffff0000, v80
  v_mul_f32 v14, v14, v16
  v_mul_f32 v18, v18, v16
  v_lshlrev_b32 v106, 16, v81
  v_and_b32 v107, 0xffff0000, v81
  v_lshlrev_b32 v108, 16, v82
  v_and_b32 v109, 0xffff0000, v82
  v_lshlrev_b32 v110, 16, v84
  v_and_b32 v111, 0xffff0000, v84
  v_lshlrev_b32 v112, 16, v85
  v_and_b32 v113, 0xffff0000, v85
  v_lshlrev_b32 v114, 16, v86
  v_and_b32 v115, 0xffff0000, v86
  v_pk_mul_f32 v[40:41], v[40:41], v[14:15] op_sel_hi:[1,0]
  v_pk_mul_f32 v[44:45], v[44:45], v[14:15] op_sel_hi:[1,0]
  v_pk_mul_f32 v[48:49], v[48:49], v[14:15] op_sel_hi:[1,0]
  v_pk_mul_f32 v[52:53], v[52:53], v[14:15] op_sel_hi:[1,0]
  v_pk_mul_f32 v[56:57], v[56:57], v[14:15] op_sel_hi:[1,0]
  v_pk_mul_f32 v[60:61], v[60:61], v[14:15] op_sel_hi:[1,0]
  v_pk_mul_f32 v[64:65], v[64:65], v[14:15] op_sel_hi:[1,0]
  v_pk_mul_f32 v[68:69], v[68:69], v[14:15] op_sel_hi:[1,0]
  v_pk_fma_f32 v[40:41], v[100:101], v[18:19], v[40:41] op_sel_hi:[1,0,1]
  v_pk_fma_f32 v[44:45], v[102:103], v[18:19], v[44:45] op_sel_hi:[1,0,1]
  v_pk_fma_f32 v[48:49], v[104:105], v[18:19], v[48:49] op_sel_hi:[1,0,1]
  v_pk_fma_f32 v[52:53], v[106:107], v[18:19], v[52:53] op_sel_hi:[1,0,1]
  v_pk_fma_f32 v[56:57], v[108:109], v[18:19], v[56:57] op_sel_hi:[1,0,1]
  v_pk_fma_f32 v[60:61], v[110:111], v[18:19], v[60:61] op_sel_hi:[1,0,1]
  v_pk_fma_f32 v[64:65], v[112:113], v[18:19], v[64:65] op_sel_hi:[1,0,1]
  v_pk_fma_f32 v[68:69], v[114:115], v[18:19], v[68:69] op_sel_hi:[1,0,1]
  v_cvt_pk_bf16_f32 v20, v40, v44
  v_cvt_pk_bf16_f32 v21, v48, v52
  v_cvt_pk_bf16_f32 v22, v56, v60
  v_cvt_pk_bf16_f32 v23, v64, v68
  s_cbranch_execz L_nost00
  buffer_store_dwordx4 v[20:23], v6, s[20:23], s36 offen offset:0
L_nost00:
  v_cvt_pk_bf16_f32 v24, v41, v45
  v_cvt_pk_bf16_f32 v25, v49, v53
  v_cvt_pk_bf16_f32 v26, v57, v61
  v_cvt_pk_bf16_f32 v27, v65, v69
  s_cbranch_execz L_nost01
  buffer_store_dwordx4 v[24:27], v6, s[20:23], s36 offen offset:16
L_nost01:
  s_endpgm
L_tail1:
  s_cbranch_execz L_dry1
  v_pk_mul_f32 v[40:41], v[40:41], v[118:119] op_sel_hi:[1,0]
  v_pk_mul_f32 v[44:45], v[44:45], v[118:119] op_sel_hi:[1,0]
  v_cvt_pk_bf16_f32 v89, v40, v41
  v_cvt_pk_bf16_f32 v90, v44, v45
  buffer_store_dwordx4 v[88:91], v3, s[28:31], s46 offen offset:0
  v_pk_mul_f32 v[48:49], v[48:49], v[118:119] op_sel_hi:[1,0]
  v_pk_mul_f32 v[52:53], v[52:53], v[118:119] op_sel_hi:[1,0]
  v_pk_mul_f32 v[56:57], v[56:57], v[118:119] op_sel_hi:[1,0]
  v_cvt_pk_bf16_f32 v92, v48, v49
  v_cvt_pk_bf16_f32 v93, v52, v53
  v_cvt_pk_bf16_f32 v94, v56, v57
  buffer_store_dwordx4 v[92:95], v3, s[28:31], s46 offen offset:1024
  v_pk_mul_f32 v[60:61], v[60:61], v[118:119] op_sel_hi:[1,0]
  v_pk_mul_f32 v[64:65], v[64:65], v[118:119] op_sel_hi:[1,0]
  v_pk_mul_f32 v[68:69], v[68:69], v[118:119] op_sel_hi:[1,0]
  v_cvt_pk_bf16_f32 v96, v60, v61
  v_cvt_pk_bf16_f32 v97, v64, v65
  v_cvt_pk_bf16_f32 v98, v68, v69
  buffer_store_dwordx4 v[96:99], v3, s[28:31], s46 offen offset:2048
L_retry1:
  buffer_load_dwordx4 v[76:79], v3, s[28:31], s42 offen offset:0 sc1
  buffer_load_dwordx4 v[80:83], v3, s[28:31], s42 offen offset:1024 sc1
  buffer_load_dwordx4 v[84:87], v3, s[28:31], s42 offen offset:2048 sc1
  s_add_u32 s6, s6, 1
  s_cmp_gt_u32 s6, 0x400000
  s_cbranch_scc1 L_got1
L_dry1:
  s_waitcnt vmcnt(0)
L_chk1:
  v_xor_b32 v16, v79, v10
  v_max_f32 v18, v88, v76
  v_bitop3_b32 v16, v16, v83, v10 bitop3:0xf6
  v_sub_f32 v17, v88, v18
  v_bitop3_b32 v16, v16, v87, v10 bitop3:0xf6
  v_sub_f32 v18, v76, v18
  v_cmp_ne_u32 vcc, 0, v16
  v_exp_f32 v14, v17
  v_exp_f32 v18, v18
  s_cbranch_vccnz L_retry1
L_got1:
  v_lshlrev_b32 v100, 16, v77
  v_and_b32 v101, 0xffff0000, v77
  v_add_f32 v16, v14, v18
  v_mul_f32 v14, v14, v118
  v_rcp_f32 v16, v16
  v_lshlrev_b32 v102, 16, v78
  v_and_b32 v103, 0xffff0000, v78
  v_lshlrev_b32 v104, 16, v80
  v_and_b32 v105, 0xffff0000, v80
  v_mul_f32 v14, v14, v16
  v_mul_f32 v18, v18, v16
  v_lshlrev_b32 v106, 16, v81
  v_and_b32 v107, 0xffff0000, v81
  v_lshlrev_b32 v108, 16, v82
  v_and_b32 v109, 0xffff0000, v82
  v_lshlrev_b32 v110, 16, v84
  v_and_b32 v111, 0xffff0000, v84
  v_lshlrev_b32 v112, 16, v85
  v_and_b32 v113, 0xffff0000, v85
  v_lshlrev_b32 v114, 16, v86
  v_and_b32 v115, 0xffff0000, v86
  v_pk_mul_f32 v[42:43], v[42:43], v[14:15] op_sel_hi:[1,0]
  v_pk_mul_f32 v[46:47], v[46:47], v[14:15] op_sel_hi:[1,0]
  v_pk_mul_f32 v[50:51], v[50:51], v[14:15] op_sel_hi:[1,0]
  v_pk_mul_f32 v[54:55], v[54:55], v[14:15] op_sel_hi:[1,0]
  v_pk_mul_f32 v[58:59], v[58:59], v[14:15] op_sel_hi:[1,0]
  v_pk_mul_f32 v[62:63], v[62:63], v[14:15] op_sel_hi:[1,0]
  v_pk_mul_f32 v[66:67], v[66:67], v[14:15] op_sel_hi:[1,0]
  v_pk_mul_f32 v[70:71], v[70:71], v[14:15] op_sel_hi:[1,0]
  v_pk_fma_f32 v[42:43], v[100:101], v[18:19], v[42:43] op_sel_hi:[1,0,1]
  v_pk_fma_f32 v[46:47], v[102:103], v[18:19], v[46:47] op_sel_hi:[1,0,1]
  v_pk_fma_f32 v[50:51], v[104:105], v[18:19], v[50:51] op_sel_hi:[1,0,1]
  v_pk_fma_f32 v[54:55], v[106:107], v[18:19], v[54:55] op_sel_hi:[1,0,1]
  v_pk_fma_f32 v[58:59], v[108:109], v[18:19], v[58:59] op_sel_hi:[1,0,1]
  v_pk_fma_f32 v[62:63], v[110:111], v[18:19], v[62:63] op_sel_hi:[1,0,1]
  v_pk_fma_f32 v[66:67], v[112:113], v[18:19], v[66:67] op_sel_hi:[1,0,1]
  v_pk_fma_f32 v[70:71], v[114:115], v[18:19], v[70:71] op_sel_hi:[1,0,1]
  v_cvt_pk_bf16_f32 v20, v42, v46
  v_cvt_pk_bf16_f32 v21, v50, v54
  v_cvt_pk_bf16_f32 v22, v58, v62
  v_cvt_pk_bf16_f32 v23, v66, v70
  s_cbranch_execz L_nost10
  buffer_store_dwordx4 v[20:23], v6, s[20:23], s36 offen offset:32
L_nost10:
  v_cvt_pk_bf16_f32 v24, v43, v47
  v_cvt_pk_bf16_f32 v25, v51, v55
  v_cvt_pk_bf16_f32 v26, v59, v63
  v_cvt_pk_bf16_f32 v27, v67, v71
  s_cbranch_execz L_nost11
  buffer_store_dwordx4 v[24:27], v6, s[20:23], s36 offen offset:48
L_nost11:
  s_endpgm
L_end:
  s_endpgm
L_helper:
  s_mov_b32 s37, 0x3e0293ee
  s_mov_b32 s38, 0x05040100
  s_mov_b32 s39, 0x07060302
  s_lshl_b32 s42, s4, 14
  s_lshl_b32 s40, s5, 13
  s_add_u32 s42, s42, s40
  s_xor_b32 s46, s42, 8192
  s_mov_b32 s6, 0
  s_cmp_eq_u32 s3, 1
  s_cbranch_scc0 L_hwarm
  s_mov_b64 exec, 1
  s_cmp_lg_u32 s2, 0
  s_cbranch_scc1 L_hpoll
  s_or_b32 s44, s44, 1
  v_mov_b32 v10, s44
  buffer_store_dword v10, v12, s[24:27], 0 offen sc1
  s_branch L_hgot
L_hpoll:
  s_sleep 48
  buffer_load_dword v10, v12, s[24:27], 0 offen sc1
  s_add_u32 s6, s6, 1
  s_waitcnt vmcnt(0)
  v_readfirstlane_b32 s41, v10
  s_cmp_gt_u32 s6, 0x100000
  s_cselect_b32 s41, 1, s41
  s_cmp_eq_u32 s41, 0
  s_cbranch_scc1 L_hpoll
L_hgot:
  v_mov_b32 v11, 0
  s_getreg_b32 s40, hwreg(HW_REG_XCC_ID)
  s_and_b32 s40, s40, 15
  v_readfirstlane_b32 s44, v10
  s_mul_i32 s40, s40, 0x9e3779b1
  s_xor_b32 s40, s40, s44
  v_mov_b32 v18, s40
  buffer_store_dword v18, v4, s[28:31], s46 offen offset:3072
  s_mov_b32 s6, 0
L_hask:
  s_sleep 24
  buffer_load_dword v19, v4, s[28:31], s42 offen offset:3072 sc1
  s_add_u32 s6, s6, 1
  s_cmp_gt_u32 s6, 6
  s_cbranch_scc1 L_hdone
  s_waitcnt vmcnt(0)
  v_readfirstlane_b32 s41, v19
  s_cmp_eq_u32 s41, s40
  s_cbranch_scc0 L_hask
  v_mov_b32 v11, 1
L_hdone:
  ds_write_b64 v12, v[10:11]
  s_waitcnt lgkmcnt(0)
  s_lshl_b32 s47, s5, 1
  s_or_b32 s47, s47, 1
  s_mov_b64 exec, 0
  s_branch L_last
L_hwarm:
  s_mov_b32 s32, 64
  s_mov_b32 s33, -1
  s_mov_b32 s7, -1
  s_mov_b64 exec, 0
  s_cmp_eq_u32 s3, 2
  s_cbranch_scc1 L_p0
  s_branch L_p1
.fill 256, 4, 0xBF800000
  s_endpgm
.section .rodata,"a"
.p2align 6
.amdhsa_kernel standalone__gqa_softmax__sampling_kernel
  .amdhsa_next_free_vgpr 332
  .amdhsa_next_free_sgpr 64
  .amdhsa_accum_offset 216
  .amdhsa_group_segment_fixed_size 0
  .amdhsa_kernarg_size 48
  .amdhsa_user_sgpr_count 2
  .amdhsa_user_sgpr_kernarg_segment_ptr 1
  .amdhsa_system_sgpr_workgroup_id_x 1
.end_amdhsa_kernel
```
